```python
import torch

def _softmax(x, axis=-1):
    return torch.softmax(x, dim=axis)
def _gelu(x):
    return torch.nn.functional.gelu(x, approximate="tanh")
def _silu(x):
    return torch.nn.functional.silu(x)
def _sigmoid(x):
    return torch.sigmoid(x)
def _layernorm(x, axis=-1, eps=1e-5):
    m = x.mean(dim=axis, keepdim=True)
    v = x.var(dim=axis, keepdim=True, unbiased=False)
    return (x - m) / torch.sqrt(v + eps)
def _scatter_add(tgt, idx, src, axis=0):
    return tgt.clone().index_add_(axis, idx, src)
def _segment_sum(src, seg, n):
    out = torch.zeros((n,) + src.shape[1:], dtype=src.dtype)
    return out.index_add_(0, seg, src)
def _pad(x, pw):
    flat = tuple(v for pair in reversed(pw) for v in pair)
    return torch.nn.functional.pad(x, flat)

kernel_name = 'gather_scatter__kernel_systems_refs_featgraph__graph'

def setup_inputs():

    _w = (lambda a: (lambda t: t.to(torch.bfloat16) if t.is_floating_point() else t)(torch.as_tensor(a)))
    N, deg, D = 12500, 32, 128
    E = N * deg
    scale = D ** -0.5
    src = (lambda lo, hi, *s: torch.randint(lo, hi, s))(0, N, E).to(torch.int64)
    dst = (lambda lo, hi, *s: torch.randint(lo, hi, s))(0, N, E).to(torch.int64)
    return {
        "x": _w((lambda *s: torch.randn(*s, dtype=torch.bfloat16) * 0.8)(N, D)),
        "src": _w(src),
        "dst": _w(dst),
        "w_q": _w((lambda *s: torch.randn(*s, dtype=torch.bfloat16) * 0.8)(D, D) * scale),
        "w_v": _w((lambda *s: torch.randn(*s, dtype=torch.bfloat16) * 0.05)(D, D) * scale),
    }

def reference(x, src, dst, w_q, w_v):
    N, D = x.shape
    xs = x[src]
    xd = x[dst]
    q = xd @ w_q
    logits = torch.einsum('ed,ed->e', xs, q) * (float(D) ** -0.5)
    alpha = _sigmoid(logits)
    msg = alpha[:, None] * (xs @ w_v)
    return _segment_sum(msg, dst, N)
```

```asm
; @launch kernel=gs_bucket_kernel grid=(272,1,1) block=(448,1,1) lds=9216
; @launch kernel=gather_scatter__kernel_systems_refs_featgraph__graph_kernel grid=(256,1,1) block=(1024,1,1) lds=84224
.amdgcn_target "amdgcn-amd-amdhsa--gfx950"
.text
.globl gs_bucket_kernel
.p2align 8
.type gs_bucket_kernel,@function
gs_bucket_kernel:
    s_cmp_ge_u32 s2, 272
    s_cbranch_scc1 K1_END
    s_load_dwordx4 s[4:7], s[0:1], 8
    s_load_dwordx2 s[12:13], s[0:1], 56
    s_load_dwordx4 s[8:11], s[0:1], 24
    s_cmp_lt_u32 s2, 16
    s_cselect_b32 s14, 272, 0
    s_add_u32 s2, s2, s14
    s_sub_u32 s2, s2, 16
    s_cmp_ge_u32 s2, 256
    s_cbranch_scc1 K1_WPREP
    s_mul_i32 s14, s2, 6256
    v_lshlrev_b32 v3, 4, v0
    v_add_u32 v4, s14, v3
    s_movk_i32 s15, 391
    s_cmp_eq_u32 s2, 255
    s_cselect_b32 s15, 295, s15
    v_cmp_gt_u32 vcc, s15, v0
    s_mov_b64 s[32:33], vcc
    v_mov_b32 v7, 0x7ffffff0
    v_cndmask_b32 v4, v7, v4, vcc
    s_waitcnt lgkmcnt(0)
    s_mov_b32 s20, s6
    s_and_b32 s21, s7, 0xffff
    s_mov_b32 s22, 0x186a00
    s_mov_b32 s23, 0x20000
    buffer_load_dwordx4 v[8:11], v4, s[20:23], 0 offen
    s_mov_b32 s16, s4
    s_and_b32 s17, s5, 0xffff
    s_mov_b32 s18, 0x186a00
    s_mov_b32 s19, 0x20000
    buffer_load_dwordx4 v[12:15], v4, s[16:19], 0 offen
    s_mov_b32 s24, s12
    s_and_b32 s25, s13, 0xffff
    s_mov_b32 s26, 0x1e0000
    s_mov_b32 s27, 0x20000
    v_and_b32 v1, 255, v0
    v_lshlrev_b32 v1, 2, v1
    v_mov_b32 v2, 0
    ds_write_b32 v1, v2
    s_and_b32 s28, s2, 7
    s_lshl_b32 s28, s28, 5
    s_lshr_b32 s29, s2, 3
    s_add_u32 s28, s28, s29
    v_mov_b32 v6, 1
    v_and_b32 v48, 63, v0
    v_lshlrev_b32 v48, 4, v48
    v_lshlrev_b32 v63, 10, v0
    s_lshl_b32 s29, s28, 2
    s_add_u32 s29, s29, 0x190000
    s_mul_i32 s30, s28, 6400
    s_waitcnt lgkmcnt(0)
    s_barrier
    s_waitcnt vmcnt(0)
    s_mov_b64 exec, s[32:33]
    v_lshlrev_b32_sdwa v24, 2, v8 dst_sel:DWORD dst_unused:UNUSED_PAD src0_sel:DWORD src1_sel:BYTE_0
    ds_add_rtn_u32 v32, v24, v6
    v_lshlrev_b32_sdwa v25, 2, v9 dst_sel:DWORD dst_unused:UNUSED_PAD src0_sel:DWORD src1_sel:BYTE_0
    ds_add_rtn_u32 v33, v25, v6
    v_lshlrev_b32_sdwa v26, 2, v10 dst_sel:DWORD dst_unused:UNUSED_PAD src0_sel:DWORD src1_sel:BYTE_0
    ds_add_rtn_u32 v34, v26, v6
    v_lshlrev_b32_sdwa v27, 2, v11 dst_sel:DWORD dst_unused:UNUSED_PAD src0_sel:DWORD src1_sel:BYTE_0
    ds_add_rtn_u32 v35, v27, v6
    v_lshrrev_b32 v7, 8, v8
    v_lshl_or_b32 v12, v7, 24, v12
    v_and_b32 v7, 7, v7
    v_lshl_or_b32 v12, v7, 20, v12
    v_lshrrev_b32 v7, 8, v9
    v_lshl_or_b32 v13, v7, 24, v13
    v_and_b32 v7, 7, v7
    v_lshl_or_b32 v13, v7, 20, v13
    v_lshrrev_b32 v7, 8, v10
    v_lshl_or_b32 v14, v7, 24, v14
    v_and_b32 v7, 7, v7
    v_lshl_or_b32 v14, v7, 20, v14
    v_lshrrev_b32 v7, 8, v11
    v_lshl_or_b32 v15, v7, 24, v15
    v_and_b32 v7, 7, v7
    v_lshl_or_b32 v15, v7, 20, v15
    s_mov_b64 exec, -1
    s_waitcnt lgkmcnt(0)
    s_barrier
    ds_read_b128 v[52:55], v48
    ds_read_b32 v56, v1
    s_waitcnt lgkmcnt(1)
    v_add_u32 v49, v52, v53
    v_add_u32 v50, v49, v54
    v_add_u32 v57, v50, v55
    v_add_u32 v51, v50, v55
    s_nop 1
    v_add_u32_dpp v57, v57, v57 row_shr:1 row_mask:0xf bank_mask:0xf bound_ctrl:1
    s_nop 1
    v_add_u32_dpp v57, v57, v57 row_shr:2 row_mask:0xf bank_mask:0xf bound_ctrl:1
    s_nop 1
    v_add_u32_dpp v57, v57, v57 row_shr:4 row_mask:0xf bank_mask:0xf bound_ctrl:1
    s_nop 1
    v_add_u32_dpp v57, v57, v57 row_shr:8 row_mask:0xf bank_mask:0xf bound_ctrl:1
    s_nop 1
    v_add_u32_dpp v57, v57, v57 row_bcast:15 row_mask:0xa bank_mask:0xf
    s_nop 1
    v_add_u32_dpp v57, v57, v57 row_bcast:31 row_mask:0xc bank_mask:0xf
    v_sub_u32 v58, v57, v51
    v_add_u32 v59, v58, v52
    v_add_u32 v60, v58, v49
    v_add_u32 v61, v58, v50
    ds_write_b128 v48, v[58:61] offset:1024
    ds_read_b32 v40, v24 offset:1024
    ds_read_b32 v41, v25 offset:1024
    ds_read_b32 v42, v26 offset:1024
    ds_read_b32 v43, v27 offset:1024
    ds_read_b32 v62, v1 offset:1024
    s_mov_b64 exec, s[32:33]
    s_waitcnt lgkmcnt(1)
    v_add_lshl_u32 v40, v40, v32, 2
    ds_write_b32 v40, v12 offset:2048
    v_add_lshl_u32 v41, v41, v33, 2
    ds_write_b32 v41, v13 offset:2048
    v_add_lshl_u32 v42, v42, v34, 2
    ds_write_b32 v42, v14 offset:2048
    v_add_lshl_u32 v43, v43, v35, 2
    ds_write_b32 v43, v15 offset:2048
    s_mov_b64 exec, -1
    v_cmp_gt_u32 vcc, 256, v0
    s_waitcnt lgkmcnt(4)
    v_lshl_or_b32 v62, v56, 16, v62
    s_mov_b64 exec, vcc
    s_cbranch_execz K1_NOTAB
    buffer_store_dword v62, v63, s[24:27], s29 offen
K1_NOTAB:
    s_mov_b64 exec, -1
    s_waitcnt lgkmcnt(0)
    s_barrier
    ds_read_b128 v[8:11], v3 offset:2048
    s_mov_b64 exec, s[32:33]
    s_cbranch_execz K1_D
    s_waitcnt lgkmcnt(0)
    buffer_store_dwordx4 v[8:11], v3, s[24:27], s30 offen
K1_D:
    s_mov_b64 exec, -1
    s_endpgm
K1_WPREP:
    v_cmp_gt_u32 vcc, 256, v0
    s_mov_b64 exec, vcc
    s_cbranch_execz K1_END
    s_sub_u32 s14, s2, 256
    s_lshr_b32 s15, s14, 3
    s_and_b32 s28, s14, 7
    v_and_b32 v1, 15, v0
    v_bfe_u32 v2, v0, 4, 2
    v_lshrrev_b32 v3, 6, v0
    v_lshlrev_b32 v3, 13, v3
    v_lshl_add_u32 v3, v2, 11, v3
    v_lshl_add_u32 v3, v1, 1, v3
    s_lshl_b32 s29, s28, 5
    v_add_u32 v3, s29, v3
    v_lshlrev_b32 v4, 4, v0
    s_lshl_b32 s30, s14, 12
    s_add_u32 s30, s30, 0x1d0000
    s_cmp_eq_u32 s15, 0
    s_waitcnt lgkmcnt(0)
    s_cselect_b32 s16, s8, s10
    s_cselect_b32 s17, s9, s11
    s_and_b32 s17, s17, 0xffff
    s_mov_b32 s18, 0x8000
    s_mov_b32 s19, 0x20000
    s_mov_b32 s24, s12
    s_and_b32 s25, s13, 0xffff
    s_mov_b32 s26, 0x1e0000
    s_mov_b32 s27, 0x20000
    buffer_load_ushort v8, v3, s[16:19], 0 offen offset:0
    buffer_load_ushort v9, v3, s[16:19], 0 offen offset:256
    buffer_load_ushort v10, v3, s[16:19], 0 offen offset:512
    buffer_load_ushort v11, v3, s[16:19], 0 offen offset:768
    buffer_load_ushort v12, v3, s[16:19], 0 offen offset:1024
    buffer_load_ushort v13, v3, s[16:19], 0 offen offset:1280
    buffer_load_ushort v14, v3, s[16:19], 0 offen offset:1536
    buffer_load_ushort v15, v3, s[16:19], 0 offen offset:1792
    s_waitcnt vmcnt(0)
    v_lshl_or_b32 v16, v9, 16, v8
    v_lshl_or_b32 v17, v11, 16, v10
    v_lshl_or_b32 v18, v13, 16, v12
    v_lshl_or_b32 v19, v15, 16, v14
    buffer_store_dwordx4 v[16:19], v4, s[24:27], s30 offen
K1_END:
    s_endpgm
.globl gather_scatter__kernel_systems_refs_featgraph__graph_kernel
.p2align 8
.type gather_scatter__kernel_systems_refs_featgraph__graph_kernel,@function
gather_scatter__kernel_systems_refs_featgraph__graph_kernel:
    s_cmp_ge_u32 s2, 256
    s_cbranch_scc1 K2_END
    s_load_dwordx2 s[8:9], s[0:1], 56
    s_load_dwordx2 s[4:5], s[0:1], 0
    s_load_dwordx2 s[6:7], s[0:1], 40
    v_lshrrev_b32 v1, 6, v0
    s_and_b32 s3, s2, 7
    s_lshl_b32 s3, s3, 5
    v_readfirstlane_b32 s10, v1
    s_lshr_b32 s40, s2, 3
    s_add_u32 s3, s3, s40
    v_and_b32 v32, 0x3fc, v0
    s_lshl_b32 s42, s3, 10
    s_add_u32 s42, s42, 0x190000
    s_lshl_b32 s41, s3, 8
    v_lshrrev_b32 v33, 4, v0
    v_and_b32 v34, 15, v0
    v_lshlrev_b32 v35, 16, v33
    v_lshl_or_b32 v35, v34, 4, v35
    v_add_u32 v125, s41, v35
    s_waitcnt lgkmcnt(0)
    s_mov_b32 s24, s8
    s_and_b32 s25, s9, 0xffff
    s_mov_b32 s26, 0x1e0000
    s_mov_b32 s27, 0x20000
    buffer_load_dword v37, v32, s[24:27], s42 offen
    s_mov_b32 s16, s4
    s_and_b32 s17, s5, 0xffff
    s_mov_b32 s18, 0x30d400
    s_mov_b32 s19, 0x20000
    buffer_load_dwordx4 v[40:43], v125, s[16:19], 0 offen
    v_and_b32 v1, 63, v0
    v_lshlrev_b32 v36, 4, v1
    s_lshl_b32 s45, s10, 12
    s_add_u32 s45, s45, 0x1d0000
    s_cmp_ge_u32 s10, 8
    s_cbranch_scc1 K2_NOWQ
    buffer_load_dwordx4 v[48:51], v36, s[24:27], s45 offen offset:0
    buffer_load_dwordx4 v[52:55], v36, s[24:27], s45 offen offset:1024
    buffer_load_dwordx4 v[56:59], v36, s[24:27], s45 offen offset:2048
    buffer_load_dwordx4 v[60:63], v36, s[24:27], s45 offen offset:3072
K2_NOWQ:
    v_lshrrev_b32 v38, 2, v0
    v_mul_u32_u24 v13, 6400, v38
    v_and_b32 v44, 3, v0
    v_lshl_add_u32 v13, v44, 4, v13
    v_lshlrev_b32 v19, 2, v44
    v_mov_b64 v[44:45], 0
    v_mov_b64 v[46:47], 0
    v_lshlrev_b32 v38, 4, v0
    ds_write_b128 v38, v[44:47] offset:1024
    v_and_b32 v39, 127, v0
    v_lshlrev_b32 v39, 2, v39
    ds_write_b32 v39, v44
    v_and_b32 v38, 15, v33
    v_xor_b32 v38, v34, v38
    v_lshlrev_b32 v38, 4, v38
    v_lshl_or_b32 v127, v33, 8, v38
    s_and_b32 s44, s10, 7
    v_and_b32 v32, 15, v1
    v_lshrrev_b32 v33, 4, v1
    s_lshl_b32 s49, s44, 1
    v_lshrrev_b32 v38, 1, v33
    v_add_u32 v38, s49, v38
    v_and_b32 v39, 1, v33
    v_lshlrev_b32 v39, 3, v39
    v_lshl_or_b32 v39, v32, 8, v39
    s_cmp_lt_u32 s10, 8
    s_cselect_b32 s49, 7, 15
    v_and_b32 v34, s49, v32
    v_xor_b32 v38, v38, v34
    v_lshl_or_b32 v126, v38, 4, v39
    v_xor_b32 v38, v33, v32
    v_lshlrev_b32 v38, 4, v38
    v_lshl_or_b32 v120, v32, 8, v38
    v_xor_b32 v121, 64, v120
    v_xor_b32 v122, 0x80, v120
    v_xor_b32 v123, 0xc0, v120
    v_and_b32 v3, 7, v1
    v_and_b32 v6, 3, v1
    v_lshlrev_b32 v3, 4, v3
    v_mul_u32_u24 v6, 0x1111, v6
    v_mov_b32 v5, v3
    v_lshlrev_b32 v7, 2, v33
    v_bfe_u32 v39, v1, 2, 1
    v_lshl_add_u32 v7, v39, 1, v7
    v_bfe_u32 v39, v1, 3, 1
    v_add_u32 v7, v39, v7
    v_lshrrev_b32 v39, 5, v1
    v_lshl_or_b32 v9, v39, 7, v3
    v_and_b32 v39, 1, v33
    v_lshl_or_b32 v9, v39, 3, v9
    v_lshrrev_b32 v124, 3, v1
    v_lshlrev_b32 v124, 2, v124
    v_add_u32 v124, 50176, v124
    v_mov_b64 v[20:21], 0
    v_mov_b64 v[22:23], 0
    s_mov_b32 s12, s4
    s_and_b32 s13, s5, 0xffff
    s_or_b32 s13, s13, 0x1000000
    s_mov_b32 s14, 0x30d4
    s_mov_b32 s15, 0x20000
    s_mov_b32 s20, s6
    s_and_b32 s21, s7, 0xffff
    s_mov_b32 s22, 0x30d400
    s_mov_b32 s23, 0x20000
    s_mov_b32 s11, 0
    s_mov_b32 s38, 0x00ff00ff
    s_mov_b32 s39, 0x00ff00ff
    s_and_b32 s47, s10, 3
    s_lshl_b32 s47, s47, 2
    s_lshr_b32 s40, s10, 2
    s_add_u32 s47, s47, s40
    s_cmp_ge_u32 s10, 8
    s_cbranch_scc1 K2_TABB
    s_waitcnt vmcnt(5)
    s_branch K2_TABC
K2_TABB:
    s_waitcnt vmcnt(1)
K2_TABC:
    v_and_b32 v38, 0xffff, v37
    v_lshrrev_b32 v37, 16, v37
    v_lshl_add_u32 v13, v38, 2, v13
    v_sub_u32 v19, v37, v19
    buffer_load_dwordx4 v[112:115], v13, s[24:27], 0 offen
    s_cmp_ge_u32 s10, 8
    s_cbranch_scc1 K2_XWB
    s_waitcnt vmcnt(5)
    s_branch K2_XWC
K2_XWB:
    s_waitcnt vmcnt(1)
K2_XWC:
    ds_write_b128 v127, v[40:43] offset:33792
    v_cmp_lt_i32 vcc, 16, v19
    s_mov_b32 s43, 0
    s_cmp_eq_u64 vcc, 0
    s_cbranch_scc1 K2_NOB_r0
    s_mov_b32 s43, 1
    buffer_load_dwordx4 v[116:119], v13, s[24:27], 0 offen offset:64
K2_NOB_r0:
    s_waitcnt lgkmcnt(0)
    s_barrier
    s_cmp_ge_u32 s10, 8
    s_cbranch_scc1 K2_PF
    ds_read_b128 v[64:67], v120 offset:33792
    ds_read_b128 v[68:71], v121 offset:33792
    ds_read_b128 v[72:75], v122 offset:33792
    ds_read_b128 v[76:79], v123 offset:33792
    ds_read_b128 v[80:83], v120 offset:37888
    ds_read_b128 v[84:87], v121 offset:37888
    ds_read_b128 v[88:91], v122 offset:37888
    ds_read_b128 v[92:95], v123 offset:37888
    ds_read_b128 v[96:99], v120 offset:41984
    ds_read_b128 v[100:103], v121 offset:41984
    ds_read_b128 v[104:107], v122 offset:41984
    ds_read_b128 v[108:111], v123 offset:41984
    s_waitcnt vmcnt(1)
    s_mov_b32 s50, 0xbe0293ee
    s_mov_b32 s51, s50
    s_waitcnt lgkmcnt(8)
    v_mfma_f32_16x16x32_bf16 v[24:27], v[48:51], v[64:67], 0
    v_mfma_f32_16x16x32_bf16 v[24:27], v[52:55], v[68:71], v[24:27]
    v_mfma_f32_16x16x32_bf16 v[24:27], v[56:59], v[72:75], v[24:27]
    v_mfma_f32_16x16x32_bf16 v[24:27], v[60:63], v[76:79], v[24:27]
    s_waitcnt lgkmcnt(4)
    v_mfma_f32_16x16x32_bf16 v[28:31], v[48:51], v[80:83], 0
    v_mfma_f32_16x16x32_bf16 v[28:31], v[52:55], v[84:87], v[28:31]
    v_mfma_f32_16x16x32_bf16 v[28:31], v[56:59], v[88:91], v[28:31]
    v_mfma_f32_16x16x32_bf16 v[28:31], v[60:63], v[92:95], v[28:31]
    ds_read_b128 v[64:67], v120 offset:46080
    ds_read_b128 v[68:71], v121 offset:46080
    ds_read_b128 v[72:75], v122 offset:46080
    ds_read_b128 v[76:79], v123 offset:46080
    s_waitcnt lgkmcnt(4)
    v_mfma_f32_16x16x32_bf16 v[40:43], v[48:51], v[96:99], 0
    v_mfma_f32_16x16x32_bf16 v[40:43], v[52:55], v[100:103], v[40:43]
    v_mfma_f32_16x16x32_bf16 v[40:43], v[56:59], v[104:107], v[40:43]
    v_mfma_f32_16x16x32_bf16 v[40:43], v[60:63], v[108:111], v[40:43]
    s_waitcnt lgkmcnt(0)
    v_mfma_f32_16x16x32_bf16 v[44:47], v[48:51], v[64:67], 0
    v_mfma_f32_16x16x32_bf16 v[44:47], v[52:55], v[68:71], v[44:47]
    v_mfma_f32_16x16x32_bf16 v[44:47], v[56:59], v[72:75], v[44:47]
    v_mfma_f32_16x16x32_bf16 v[44:47], v[60:63], v[76:79], v[44:47]
    v_pk_mul_f32 v[24:25], v[24:25], s[50:51]
    v_pk_mul_f32 v[26:27], v[26:27], s[50:51]
    v_cvt_pk_bf16_f32 v80, v24, v25
    v_cvt_pk_bf16_f32 v81, v26, v27
    ds_write_b64 v126, v[80:81] offset:17408
    v_pk_mul_f32 v[28:29], v[28:29], s[50:51]
    v_pk_mul_f32 v[30:31], v[30:31], s[50:51]
    v_cvt_pk_bf16_f32 v82, v28, v29
    v_cvt_pk_bf16_f32 v83, v30, v31
    ds_write_b64 v126, v[82:83] offset:21504
    v_pk_mul_f32 v[40:41], v[40:41], s[50:51]
    v_pk_mul_f32 v[42:43], v[42:43], s[50:51]
    v_cvt_pk_bf16_f32 v84, v40, v41
    v_cvt_pk_bf16_f32 v85, v42, v43
    ds_write_b64 v126, v[84:85] offset:25600
    s_nop 1
    v_pk_mul_f32 v[44:45], v[44:45], s[50:51]
    v_pk_mul_f32 v[46:47], v[46:47], s[50:51]
    v_cvt_pk_bf16_f32 v86, v44, v45
    v_cvt_pk_bf16_f32 v87, v46, v47
    ds_write_b64 v126, v[86:87] offset:29696
    s_branch K2_PASS1
K2_PF:
    buffer_load_dwordx4 v[96:99], v36, s[24:27], s45 offen offset:0
    buffer_load_dwordx4 v[100:103], v36, s[24:27], s45 offen offset:1024
    buffer_load_dwordx4 v[104:107], v36, s[24:27], s45 offen offset:2048
    buffer_load_dwordx4 v[108:111], v36, s[24:27], s45 offen offset:3072
    s_lshr_b32 s40, s2, 3
    s_mul_i32 s40, s40, 100096
    s_sub_u32 s41, s10, 8
    s_lshl_b32 s46, s41, 13
    s_add_u32 s40, s40, s46
    s_add_u32 s40, s40, 0
    v_lshlrev_b32 v38, 7, v1
    v_add_u32 v38, s40, v38
    s_cmp_lt_u32 s41, 5
    s_cselect_b32 s46, 0, 0x40000000
    v_add_u32 v39, s46, v38
    buffer_load_dword v95, v39, s[16:19], 0 offen
K2_PASS1:
    v_mov_b32 v16, 1
    v_lshlrev_b32 v14, 2, v1
    v_mov_b32 v18, 256
    s_cmp_lt_u32 s10, 8
    s_cbranch_scc1 K2_SW_0
    s_cmp_lg_u32 s11, 0
    s_cbranch_scc1 K2_SW_0
    s_waitcnt vmcnt(5)
    s_branch K2_SW_1
K2_SW_0:
    s_waitcnt vmcnt(0)
K2_SW_1:
    v_cmp_lt_i32 s[52:53], 0, v19
    v_cmp_lt_i32 s[54:55], 1, v19
    v_cmp_lt_i32 s[56:57], 2, v19
    v_cmp_lt_i32 s[58:59], 3, v19
    s_mov_b64 exec, s[52:53]
    v_lshlrev_b32_sdwa v64, 2, v112 dst_sel:DWORD dst_unused:UNUSED_PAD src0_sel:DWORD src1_sel:BYTE_3
    ds_add_rtn_u32 v72, v64, v16
    s_mov_b64 exec, s[54:55]
    v_lshlrev_b32_sdwa v65, 2, v113 dst_sel:DWORD dst_unused:UNUSED_PAD src0_sel:DWORD src1_sel:BYTE_3
    ds_add_rtn_u32 v73, v65, v16
    s_mov_b64 exec, s[56:57]
    v_lshlrev_b32_sdwa v66, 2, v114 dst_sel:DWORD dst_unused:UNUSED_PAD src0_sel:DWORD src1_sel:BYTE_3
    ds_add_rtn_u32 v74, v66, v16
    s_mov_b64 exec, s[58:59]
    v_lshlrev_b32_sdwa v67, 2, v115 dst_sel:DWORD dst_unused:UNUSED_PAD src0_sel:DWORD src1_sel:BYTE_3
    ds_add_rtn_u32 v75, v67, v16
    s_mov_b64 exec, -1
    s_cmp_eq_u32 s43, 0
    s_cbranch_scc1 K2_P1_NOB
    v_cmp_lt_i32 vcc, 16, v19
    s_mov_b64 exec, vcc
    v_lshlrev_b32_sdwa v68, 2, v116 dst_sel:DWORD dst_unused:UNUSED_PAD src0_sel:DWORD src1_sel:BYTE_3
    ds_add_rtn_u32 v76, v68, v16
    v_cmp_lt_i32 vcc, 17, v19
    s_mov_b64 exec, vcc
    v_lshlrev_b32_sdwa v69, 2, v117 dst_sel:DWORD dst_unused:UNUSED_PAD src0_sel:DWORD src1_sel:BYTE_3
    ds_add_rtn_u32 v77, v69, v16
    v_cmp_lt_i32 vcc, 18, v19
    s_mov_b64 exec, vcc
    v_lshlrev_b32_sdwa v70, 2, v118 dst_sel:DWORD dst_unused:UNUSED_PAD src0_sel:DWORD src1_sel:BYTE_3
    ds_add_rtn_u32 v78, v70, v16
    v_cmp_lt_i32 vcc, 19, v19
    s_mov_b64 exec, vcc
    v_lshlrev_b32_sdwa v71, 2, v119 dst_sel:DWORD dst_unused:UNUSED_PAD src0_sel:DWORD src1_sel:BYTE_3
    ds_add_rtn_u32 v79, v71, v16
    s_mov_b64 exec, -1
    v_cmp_lt_i32 vcc, 32, v19
    s_cmp_eq_u64 vcc, 0
    s_cbranch_scc1 K2_P1_NOB
    s_mov_b64 exec, vcc
    ds_write_b32 v18, v16
    s_mov_b64 exec, -1
K2_P1_NOB:
    s_waitcnt lgkmcnt(0)
    s_barrier
    ds_read_b32 v10, v14
    ds_read_b32 v15, v14
    ds_read_b32 v18, v18
    s_waitcnt lgkmcnt(0)
    v_readfirstlane_b32 s46, v18
    s_nop 1
    v_add_u32_dpp v10, v10, v10 row_shr:1 row_mask:0xf bank_mask:0xf bound_ctrl:1
    s_nop 1
    v_add_u32_dpp v10, v10, v10 row_shr:2 row_mask:0xf bank_mask:0xf bound_ctrl:1
    s_nop 1
    v_add_u32_dpp v10, v10, v10 row_shr:4 row_mask:0xf bank_mask:0xf bound_ctrl:1
    s_nop 1
    v_add_u32_dpp v10, v10, v10 row_shr:8 row_mask:0xf bank_mask:0xf bound_ctrl:1
    s_nop 1
    v_add_u32_dpp v10, v10, v10 row_bcast:15 row_mask:0xa bank_mask:0xf
    s_nop 1
    v_add_u32_dpp v10, v10, v10 row_bcast:31 row_mask:0xc bank_mask:0xf
    s_nop 0
    v_readlane_b32 s37, v10, 63
    v_sub_u32 v16, v10, v15
    v_add_u32 v17, v16, v10
    v_cmp_lt_u32 s[32:33], 0, v15
    ds_bpermute_b32 v80, v64, v16
    ds_bpermute_b32 v81, v65, v16
    ds_bpermute_b32 v82, v66, v16
    ds_bpermute_b32 v83, v67, v16
    s_mul_i32 s40, s47, s37
    s_add_u32 s41, s40, s37
    s_add_u32 s40, s40, 7
    s_lshr_b32 s40, s40, 3
    s_add_u32 s41, s41, 7
    s_lshr_b32 s41, s41, 3
    v_cmp_le_u32 vcc, s40, v17
    s_and_b64 s[32:33], s[32:33], vcc
    v_cmp_gt_u32 vcc, s41, v17
    s_and_b64 s[32:33], s[32:33], vcc
    s_mov_b32 s28, 0
    s_mov_b32 s31, 0
    s_cmp_eq_u64 s[32:33], 0
    s_cbranch_scc1 K2_NOWORK_A
    s_ff1_i32_b64 s40, s[32:33]
    s_flbit_i32_b64 s41, s[32:33]
    s_sub_u32 s41, 63, s41
    v_readlane_b32 s28, v16, s40
    v_readlane_b32 s42, v10, s41
K2_NOWORK_A:
    s_waitcnt lgkmcnt(0)
    s_mov_b64 exec, s[52:53]
    v_add_lshl_u32 v80, v80, v72, 2
    ds_write_b32 v80, v112 offset:50176
    s_mov_b64 exec, s[54:55]
    v_add_lshl_u32 v81, v81, v73, 2
    ds_write_b32 v81, v113 offset:50176
    s_mov_b64 exec, s[56:57]
    v_add_lshl_u32 v82, v82, v74, 2
    ds_write_b32 v82, v114 offset:50176
    s_mov_b64 exec, s[58:59]
    v_add_lshl_u32 v83, v83, v75, 2
    ds_write_b32 v83, v115 offset:50176
    s_mov_b64 exec, -1
    s_cmp_eq_u32 s43, 0
    s_cbranch_scc1 K2_P2_NOB
    ds_bpermute_b32 v84, v68, v16
    ds_bpermute_b32 v85, v69, v16
    ds_bpermute_b32 v86, v70, v16
    ds_bpermute_b32 v87, v71, v16
    s_waitcnt lgkmcnt(0)
    v_cmp_lt_i32 vcc, 16, v19
    s_mov_b64 exec, vcc
    v_add_lshl_u32 v84, v84, v76, 2
    ds_write_b32 v84, v116 offset:50176
    v_cmp_lt_i32 vcc, 17, v19
    s_mov_b64 exec, vcc
    v_add_lshl_u32 v85, v85, v77, 2
    ds_write_b32 v85, v117 offset:50176
    v_cmp_lt_i32 vcc, 18, v19
    s_mov_b64 exec, vcc
    v_add_lshl_u32 v86, v86, v78, 2
    ds_write_b32 v86, v118 offset:50176
    v_cmp_lt_i32 vcc, 19, v19
    s_mov_b64 exec, vcc
    v_add_lshl_u32 v87, v87, v79, 2
    ds_write_b32 v87, v119 offset:50176
    s_mov_b64 exec, -1
K2_P2_NOB:
    s_cmp_eq_u64 s[32:33], 0
    s_cbranch_scc1 K2_NOWORK_B
    s_sub_u32 s31, s42, s28
    s_add_u32 s31, s31, 15
    s_lshr_b32 s31, s31, 4
    s_min_u32 s31, s31, 600
K2_NOWORK_B:
    s_lshl_b32 s40, s28, 2
    v_add_u32 v8, s40, v124
    s_waitcnt lgkmcnt(0)
    s_barrier
    s_cmp_eq_u32 s31, 0
    s_cbranch_scc1 K2_IDLE
    ds_read_u16 v2, v8 offset:0
    ds_read_u16 v4, v8 offset:32
    ds_read_u16 v11, v8 offset:2
    ds_read_u16 v12, v8 offset:34
    s_setprio 3
    s_waitcnt lgkmcnt(2)
    buffer_load_dwordx4 v[48:51], v[2:3], s[12:15], 0 idxen offen
    buffer_load_dwordx4 v[56:59], v[2:3], s[12:15], 0 idxen offen offset:128
    buffer_load_dwordx4 v[52:55], v[4:5], s[12:15], 0 idxen offen
    buffer_load_dwordx4 v[60:63], v[4:5], s[12:15], 0 idxen offen offset:128
    s_setprio 1
K2_PRO_DONE:
    s_waitcnt lgkmcnt(0)
    v_xor_b32 v11, v11, v3
    v_xor_b32 v12, v12, v3
    ds_read_b128 v[32:35], v11 offset:17408
    ds_read_b128 v[36:39], v11 offset:17536
    ds_read_b128 v[40:43], v12 offset:17408
    ds_read_b128 v[44:47], v12 offset:17536
    ds_read_u16 v11, v8 offset:66
    ds_read_u16 v12, v8 offset:98
    ds_read_u16 v2, v8 offset:64
    ds_read_u16 v4, v8 offset:96
    s_sub_u32 s31, s31, 1
    s_mov_b32 s29, s28
    s_mov_b32 s35, 2
    s_mov_b32 s48, -1
    s_setprio 0
    s_cmp_lt_u32 s31, 1
    s_cbranch_scc1 K2_PRIO_SET
    s_mov_b32 s48, 0
    s_setprio 1
    s_cmp_lt_u32 s31, 3
    s_cbranch_scc1 K2_PRIO_SET
    s_mov_b32 s48, 2
    s_setprio 2
    s_cmp_lt_u32 s31, 5
    s_cbranch_scc1 K2_PRIO_SET
    s_mov_b32 s48, 4
    s_setprio 3
K2_PRIO_SET:
    s_ff1_i32_b64 s34, s[32:33]
    s_bitset0_b64 s[32:33], s34
    v_readlane_b32 s30, v10, s34
    v_mov_b64 v[24:25], 0
    v_mov_b64 v[26:27], 0
    v_mov_b64 v[28:29], 0
    v_mov_b64 v[30:31], 0
K2_LOOP:
K2_STEP0:
    s_waitcnt vmcnt(0) lgkmcnt(0)
    v_dot2_f32_bf16 v14, v48, v32, 0
    v_dot2_f32_bf16 v15, v52, v40, 0
    v_dot2_f32_bf16 v14, v49, v33, v14
    v_dot2_f32_bf16 v15, v53, v41, v15
    v_dot2_f32_bf16 v14, v50, v34, v14
    v_dot2_f32_bf16 v15, v54, v42, v15
    v_dot2_f32_bf16 v14, v51, v35, v14
    v_dot2_f32_bf16 v15, v55, v43, v15
    v_dot2_f32_bf16 v14, v56, v36, v14
    v_dot2_f32_bf16 v15, v60, v44, v15
    v_dot2_f32_bf16 v14, v57, v37, v14
    v_dot2_f32_bf16 v15, v61, v45, v15
    v_dot2_f32_bf16 v14, v58, v38, v14
    v_dot2_f32_bf16 v15, v62, v46, v15
    v_dot2_f32_bf16 v14, v59, v39, v14
    v_dot2_f32_bf16 v15, v63, v47, v15
    s_cmp_eq_u32 s31, 0
    s_cbranch_scc1 K2_SKIPA0
    buffer_load_dwordx4 v[64:67], v[2:3], s[12:15], 0 idxen offen
    buffer_load_dwordx4 v[72:75], v[2:3], s[12:15], 0 idxen offen offset:128
    buffer_load_dwordx4 v[68:71], v[4:5], s[12:15], 0 idxen offen
    buffer_load_dwordx4 v[76:79], v[4:5], s[12:15], 0 idxen offen offset:128
    ds_read_u16 v2, v8 offset:128
    ds_read_u16 v4, v8 offset:160
K2_SKIPA0:
    v_xor_b32 v11, v11, v3
    v_xor_b32 v12, v12, v3
    s_add_u32 s29, s29, 16
    v_permlane32_swap_b32 v14, v15
    ds_read_b128 v[32:35], v11 offset:17408
    ds_read_b128 v[36:39], v11 offset:17536
    v_permlane16_swap_b32 v14, v15
    ds_read_b128 v[40:43], v12 offset:17408
    ds_read_b128 v[44:47], v12 offset:17536
    v_add_f32_dpp v16, v14, v14 row_shl:4 row_mask:0xf bank_mask:0x5
    v_add_f32_dpp v16, v15, v15 row_shr:4 row_mask:0xf bank_mask:0xa
    ds_read_u16 v11, v8 offset:130
    ds_read_u16 v12, v8 offset:162
    v_add_f32_dpp v16, v16, v16 quad_perm:[1,0,3,2] row_mask:0xf bank_mask:0xf
    s_nop 1
    v_add_f32_dpp v16, v16, v16 quad_perm:[2,3,0,1] row_mask:0xf bank_mask:0xf
    v_exp_f32 v16, v16
    s_nop 0
    v_add_f32 v16, 1.0, v16
    v_rcp_f32 v16, v16
    s_cmp_le_u32 s30, s29
    v_cvt_pk_bf16_f32 v17, v16, 0
    s_cbranch_scc1 K2_BND0
    s_nop 0
K2_RET0:
    v_mov_b32_dpp v20, v17 quad_perm:[0,1,2,3] row_mask:0xf bank_mask:0x5
    v_mov_b32_dpp v21, v17 row_shr:4 row_mask:0xf bank_mask:0xa
    v_mov_b32_dpp v22, v17 row_shl:4 row_mask:0xf bank_mask:0x5
    v_mov_b32_dpp v23, v17 quad_perm:[0,1,2,3] row_mask:0xf bank_mask:0xa
    s_nop 1
    v_smfmac_f32_16x16x64_bf16 v[24:27], v[20:23], v[48:55], v6
    v_smfmac_f32_16x16x64_bf16 v[28:31], v[20:23], v[56:63], v6
    s_sub_u32 s31, s31, 1
    s_cbranch_scc1 K2_LOOP_END
    s_cmp_eq_u32 s31, s48
    s_cbranch_scc1 K2_PRIO0
K2_PRIOB0:
K2_STEP1:
    s_waitcnt vmcnt(0) lgkmcnt(0)
    v_dot2_f32_bf16 v14, v64, v32, 0
    v_dot2_f32_bf16 v15, v68, v40, 0
    v_dot2_f32_bf16 v14, v65, v33, v14
    v_dot2_f32_bf16 v15, v69, v41, v15
    v_dot2_f32_bf16 v14, v66, v34, v14
    v_dot2_f32_bf16 v15, v70, v42, v15
    v_dot2_f32_bf16 v14, v67, v35, v14
    v_dot2_f32_bf16 v15, v71, v43, v15
    v_dot2_f32_bf16 v14, v72, v36, v14
    v_dot2_f32_bf16 v15, v76, v44, v15
    v_dot2_f32_bf16 v14, v73, v37, v14
    v_dot2_f32_bf16 v15, v77, v45, v15
    v_dot2_f32_bf16 v14, v74, v38, v14
    v_dot2_f32_bf16 v15, v78, v46, v15
    v_dot2_f32_bf16 v14, v75, v39, v14
    v_dot2_f32_bf16 v15, v79, v47, v15
    s_cmp_eq_u32 s31, 0
    s_cbranch_scc1 K2_SKIPA1
    buffer_load_dwordx4 v[48:51], v[2:3], s[12:15], 0 idxen offen
    buffer_load_dwordx4 v[56:59], v[2:3], s[12:15], 0 idxen offen offset:128
    buffer_load_dwordx4 v[52:55], v[4:5], s[12:15], 0 idxen offen
    buffer_load_dwordx4 v[60:63], v[4:5], s[12:15], 0 idxen offen offset:128
    ds_read_u16 v2, v8 offset:192
    ds_read_u16 v4, v8 offset:224
K2_SKIPA1:
    v_xor_b32 v11, v11, v3
    v_xor_b32 v12, v12, v3
    s_add_u32 s29, s29, 16
    v_permlane32_swap_b32 v14, v15
    ds_read_b128 v[32:35], v11 offset:17408
    ds_read_b128 v[36:39], v11 offset:17536
    v_permlane16_swap_b32 v14, v15
    ds_read_b128 v[40:43], v12 offset:17408
    ds_read_b128 v[44:47], v12 offset:17536
    v_add_f32_dpp v16, v14, v14 row_shl:4 row_mask:0xf bank_mask:0x5
    v_add_f32_dpp v16, v15, v15 row_shr:4 row_mask:0xf bank_mask:0xa
    ds_read_u16 v11, v8 offset:194
    ds_read_u16 v12, v8 offset:226
    v_add_f32_dpp v16, v16, v16 quad_perm:[1,0,3,2] row_mask:0xf bank_mask:0xf
    s_nop 1
    v_add_f32_dpp v16, v16, v16 quad_perm:[2,3,0,1] row_mask:0xf bank_mask:0xf
    v_exp_f32 v16, v16
    s_nop 0
    v_add_f32 v16, 1.0, v16
    v_rcp_f32 v16, v16
    s_cmp_le_u32 s30, s29
    v_cvt_pk_bf16_f32 v17, v16, 0
    s_cbranch_scc1 K2_BND1
    s_nop 0
K2_RET1:
    v_mov_b32_dpp v20, v17 quad_perm:[0,1,2,3] row_mask:0xf bank_mask:0x5
    v_mov_b32_dpp v21, v17 row_shr:4 row_mask:0xf bank_mask:0xa
    v_mov_b32_dpp v22, v17 row_shl:4 row_mask:0xf bank_mask:0x5
    v_mov_b32_dpp v23, v17 quad_perm:[0,1,2,3] row_mask:0xf bank_mask:0xa
    s_nop 1
    v_smfmac_f32_16x16x64_bf16 v[24:27], v[20:23], v[64:71], v6
    v_smfmac_f32_16x16x64_bf16 v[28:31], v[20:23], v[72:79], v6
    v_add_u32 v8, 128, v8
    s_sub_u32 s31, s31, 1
    s_cbranch_scc1 K2_LOOP_END
    s_cmp_eq_u32 s31, s48
    s_cbranch_scc1 K2_PRIO1
K2_PRIOB1:
    s_branch K2_STEP0
K2_BND0:
    s_sub_u32 s36, s30, s29
    s_add_u32 s36, s36, 16
    v_cmp_gt_u32 vcc, s36, v7
    s_lshl_b32 s37, s34, 8
    s_add_u32 s37, s37, 1024
    v_cndmask_b32 v18, 0, v17, vcc
    v_cndmask_b32_e64 v17, v17, 0, vcc
    s_and_b32 s40, s34, 15
    s_lshl_b32 s40, s40, 4
    v_mov_b32_dpp v20, v18 quad_perm:[0,1,2,3] row_mask:0xf bank_mask:0x5
    v_mov_b32_dpp v21, v18 row_shr:4 row_mask:0xf bank_mask:0xa
    v_mov_b32_dpp v22, v18 row_shl:4 row_mask:0xf bank_mask:0x5
    v_mov_b32_dpp v23, v18 quad_perm:[0,1,2,3] row_mask:0xf bank_mask:0xa
    s_or_b32 s37, s37, s40
    v_xor_b32 v18, s37, v9
    v_smfmac_f32_16x16x64_bf16 v[24:27], v[20:23], v[48:55], v6
    v_smfmac_f32_16x16x64_bf16 v[28:31], v[20:23], v[56:63], v6
    s_mov_b32 s30, -1
    s_cmp_eq_u64 s[32:33], 0
    s_cbranch_scc1 K2_BLAST0
    s_ff1_i32_b64 s34, s[32:33]
    s_bitset0_b64 s[32:33], s34
    v_readlane_b32 s30, v10, s34
    s_nop 2
K2_BFL0:
    v_permlane32_swap_b32 v24, v28
    v_permlane32_swap_b32 v25, v29
    v_permlane32_swap_b32 v26, v30
    v_permlane32_swap_b32 v27, v31
    v_add_f32_dpp v24, v28, v24 row_shl:8 row_mask:0xf bank_mask:0x3
    v_add_f32_dpp v25, v29, v25 row_shl:8 row_mask:0xf bank_mask:0x3
    v_add_f32_dpp v26, v30, v26 row_shl:8 row_mask:0xf bank_mask:0x3
    v_add_f32_dpp v27, v31, v27 row_shl:8 row_mask:0xf bank_mask:0x3
    s_cmp_lg_u32 s11, 0
    s_cbranch_scc1 K2_BRMW0
K2_BPK0:
    v_cvt_pk_bf16_f32 v112, v24, v25
    v_cvt_pk_bf16_f32 v113, v26, v27
    s_mov_b64 exec, s[38:39]
    ds_write_b64 v18, v[112:113]
    s_mov_b64 exec, -1
    v_mov_b64 v[24:25], 0
    v_mov_b64 v[26:27], 0
    v_mov_b64 v[28:29], 0
    v_mov_b64 v[30:31], 0
    s_cmp_le_u32 s30, s29
    s_cbranch_scc0 K2_RET0
    s_branch K2_BND0
K2_BLAST0:
    s_nop 5
    s_branch K2_BFL0
K2_BRMW0:
    ds_read_b64 v[112:113], v18
    s_waitcnt lgkmcnt(0)
    v_lshlrev_b32 v114, 16, v112
    v_and_b32 v115, 0xffff0000, v112
    v_add_f32 v24, v24, v114
    v_add_f32 v25, v25, v115
    v_lshlrev_b32 v114, 16, v113
    v_and_b32 v115, 0xffff0000, v113
    v_add_f32 v26, v26, v114
    v_add_f32 v27, v27, v115
    s_branch K2_BPK0
K2_PRIO0:
    s_cmp_eq_u32 s48, 4
    s_cbranch_scc0 K2_PRIO0_B
    s_setprio 2
    s_mov_b32 s48, 2
    s_branch K2_PRIOB0
K2_PRIO0_B:
    s_cmp_eq_u32 s48, 2
    s_cbranch_scc0 K2_PRIO0_C
    s_setprio 1
    s_mov_b32 s48, 0
    s_branch K2_PRIOB0
K2_PRIO0_C:
    s_setprio 0
    s_mov_b32 s48, -1
    s_branch K2_PRIOB0
K2_BND1:
    s_sub_u32 s36, s30, s29
    s_add_u32 s36, s36, 16
    v_cmp_gt_u32 vcc, s36, v7
    s_lshl_b32 s37, s34, 8
    s_add_u32 s37, s37, 1024
    v_cndmask_b32 v18, 0, v17, vcc
    v_cndmask_b32_e64 v17, v17, 0, vcc
    s_and_b32 s40, s34, 15
    s_lshl_b32 s40, s40, 4
    v_mov_b32_dpp v20, v18 quad_perm:[0,1,2,3] row_mask:0xf bank_mask:0x5
    v_mov_b32_dpp v21, v18 row_shr:4 row_mask:0xf bank_mask:0xa
    v_mov_b32_dpp v22, v18 row_shl:4 row_mask:0xf bank_mask:0x5
    v_mov_b32_dpp v23, v18 quad_perm:[0,1,2,3] row_mask:0xf bank_mask:0xa
    s_or_b32 s37, s37, s40
    v_xor_b32 v18, s37, v9
    v_smfmac_f32_16x16x64_bf16 v[24:27], v[20:23], v[64:71], v6
    v_smfmac_f32_16x16x64_bf16 v[28:31], v[20:23], v[72:79], v6
    s_mov_b32 s30, -1
    s_cmp_eq_u64 s[32:33], 0
    s_cbranch_scc1 K2_BLAST1
    s_ff1_i32_b64 s34, s[32:33]
    s_bitset0_b64 s[32:33], s34
    v_readlane_b32 s30, v10, s34
    s_nop 2
K2_BFL1:
    v_permlane32_swap_b32 v24, v28
    v_permlane32_swap_b32 v25, v29
    v_permlane32_swap_b32 v26, v30
    v_permlane32_swap_b32 v27, v31
    v_add_f32_dpp v24, v28, v24 row_shl:8 row_mask:0xf bank_mask:0x3
    v_add_f32_dpp v25, v29, v25 row_shl:8 row_mask:0xf bank_mask:0x3
    v_add_f32_dpp v26, v30, v26 row_shl:8 row_mask:0xf bank_mask:0x3
    v_add_f32_dpp v27, v31, v27 row_shl:8 row_mask:0xf bank_mask:0x3
    s_cmp_lg_u32 s11, 0
    s_cbranch_scc1 K2_BRMW1
K2_BPK1:
    v_cvt_pk_bf16_f32 v112, v24, v25
    v_cvt_pk_bf16_f32 v113, v26, v27
    s_mov_b64 exec, s[38:39]
    ds_write_b64 v18, v[112:113]
    s_mov_b64 exec, -1
    v_mov_b64 v[24:25], 0
    v_mov_b64 v[26:27], 0
    v_mov_b64 v[28:29], 0
    v_mov_b64 v[30:31], 0
    s_cmp_le_u32 s30, s29
    s_cbranch_scc0 K2_RET1
    s_branch K2_BND1
K2_BLAST1:
    s_nop 5
    s_branch K2_BFL1
K2_BRMW1:
    ds_read_b64 v[112:113], v18
    s_waitcnt lgkmcnt(0)
    v_lshlrev_b32 v114, 16, v112
    v_and_b32 v115, 0xffff0000, v112
    v_add_f32 v24, v24, v114
    v_add_f32 v25, v25, v115
    v_lshlrev_b32 v114, 16, v113
    v_and_b32 v115, 0xffff0000, v113
    v_add_f32 v26, v26, v114
    v_add_f32 v27, v27, v115
    s_branch K2_BPK1
K2_PRIO1:
    s_cmp_eq_u32 s48, 4
    s_cbranch_scc0 K2_PRIO1_B
    s_setprio 2
    s_mov_b32 s48, 2
    s_branch K2_PRIOB1
K2_PRIO1_B:
    s_cmp_eq_u32 s48, 2
    s_cbranch_scc0 K2_PRIO1_C
    s_setprio 1
    s_mov_b32 s48, 0
    s_branch K2_PRIOB1
K2_PRIO1_C:
    s_setprio 0
    s_mov_b32 s48, -1
    s_branch K2_PRIOB1
K2_IDLE:
    s_branch K2_LOOP_END
K2_LOOP_END:
    s_setprio 0
    s_cmp_lg_u32 s46, 0
    s_cbranch_scc1 K2_MORE
K2_NOFETCH:
    s_waitcnt vmcnt(0) lgkmcnt(0)
    s_barrier
    s_cmp_lt_u32 s10, 8
    s_cbranch_scc1 K2_EPI_WAIT
    ds_read_b128 v[32:35], v120 offset:1024
    ds_read_b128 v[36:39], v121 offset:1024
    ds_read_b128 v[40:43], v122 offset:1024
    ds_read_b128 v[44:47], v123 offset:1024
    ds_read_b128 v[48:51], v120 offset:5120
    ds_read_b128 v[52:55], v121 offset:5120
    ds_read_b128 v[56:59], v122 offset:5120
    ds_read_b128 v[60:63], v123 offset:5120
    ds_read_b128 v[64:67], v120 offset:9216
    ds_read_b128 v[68:71], v121 offset:9216
    ds_read_b128 v[72:75], v122 offset:9216
    ds_read_b128 v[76:79], v123 offset:9216
    ds_read_b128 v[80:83], v120 offset:13312
    ds_read_b128 v[84:87], v121 offset:13312
    ds_read_b128 v[88:91], v122 offset:13312
    ds_read_b128 v[92:95], v123 offset:13312
    s_waitcnt lgkmcnt(12)
    v_mfma_f32_16x16x32_bf16 v[24:27], v[96:99], v[32:35], 0
    v_mfma_f32_16x16x32_bf16 v[24:27], v[100:103], v[36:39], v[24:27]
    v_mfma_f32_16x16x32_bf16 v[24:27], v[104:107], v[40:43], v[24:27]
    v_mfma_f32_16x16x32_bf16 v[24:27], v[108:111], v[44:47], v[24:27]
    s_waitcnt lgkmcnt(8)
    v_mfma_f32_16x16x32_bf16 v[28:31], v[96:99], v[48:51], 0
    v_mfma_f32_16x16x32_bf16 v[28:31], v[100:103], v[52:55], v[28:31]
    v_mfma_f32_16x16x32_bf16 v[28:31], v[104:107], v[56:59], v[28:31]
    v_mfma_f32_16x16x32_bf16 v[28:31], v[108:111], v[60:63], v[28:31]
    s_waitcnt lgkmcnt(4)
    v_mfma_f32_16x16x32_bf16 v[112:115], v[96:99], v[64:67], 0
    v_mfma_f32_16x16x32_bf16 v[112:115], v[100:103], v[68:71], v[112:115]
    v_mfma_f32_16x16x32_bf16 v[112:115], v[104:107], v[72:75], v[112:115]
    v_mfma_f32_16x16x32_bf16 v[112:115], v[108:111], v[76:79], v[112:115]
    s_waitcnt lgkmcnt(0)
    v_mfma_f32_16x16x32_bf16 v[116:119], v[96:99], v[80:83], 0
    v_mfma_f32_16x16x32_bf16 v[116:119], v[100:103], v[84:87], v[116:119]
    v_mfma_f32_16x16x32_bf16 v[116:119], v[104:107], v[88:91], v[116:119]
    v_mfma_f32_16x16x32_bf16 v[116:119], v[108:111], v[92:95], v[116:119]
    s_nop 3
    v_cvt_pk_bf16_f32 v16, v24, v25
    v_cvt_pk_bf16_f32 v17, v26, v27
    ds_write_b64 v126, v[16:17] offset:33792
    v_cvt_pk_bf16_f32 v18, v28, v29
    v_cvt_pk_bf16_f32 v19, v30, v31
    ds_write_b64 v126, v[18:19] offset:37888
    v_cvt_pk_bf16_f32 v20, v112, v113
    v_cvt_pk_bf16_f32 v21, v114, v115
    ds_write_b64 v126, v[20:21] offset:41984
    s_nop 3
    v_cvt_pk_bf16_f32 v22, v116, v117
    v_cvt_pk_bf16_f32 v23, v118, v119
    ds_write_b64 v126, v[22:23] offset:46080
K2_EPI_WAIT:
    s_waitcnt lgkmcnt(0)
    s_barrier
    ds_read_b128 v[40:43], v127 offset:33792
    s_waitcnt lgkmcnt(0)
    buffer_store_dwordx4 v[40:43], v125, s[20:23], 0 offen nt
    s_endpgm
K2_MORE:
    s_waitcnt vmcnt(0) lgkmcnt(0)
    s_barrier
    s_add_u32 s11, s11, 1
    v_and_b32 v39, 127, v0
    v_lshlrev_b32 v39, 2, v39
    v_mov_b32 v38, 0
    ds_write_b32 v39, v38
    v_add_u32 v13, 128, v13
    v_subrev_u32 v19, 32, v19
    buffer_load_dwordx4 v[112:115], v13, s[24:27], 0 offen
    v_cmp_lt_i32 vcc, 16, v19
    s_mov_b32 s43, 0
    s_cmp_eq_u64 vcc, 0
    s_cbranch_scc1 K2_NOB_rn
    s_mov_b32 s43, 1
    buffer_load_dwordx4 v[116:119], v13, s[24:27], 0 offen offset:64
K2_NOB_rn:
    s_waitcnt lgkmcnt(0)
    s_barrier
    s_branch K2_PASS1
K2_END:
    s_endpgm
.section .rodata,"a"
.p2align 6
.amdhsa_kernel gs_bucket_kernel
  .amdhsa_next_free_vgpr 80
  .amdhsa_next_free_sgpr 64
  .amdhsa_accum_offset 80
  .amdhsa_group_segment_fixed_size 0
  .amdhsa_kernarg_size 64
  .amdhsa_user_sgpr_count 2
  .amdhsa_user_sgpr_kernarg_segment_ptr 1
  .amdhsa_system_sgpr_workgroup_id_x 1
  .amdhsa_float_denorm_mode_32 3
.end_amdhsa_kernel
.p2align 6
.amdhsa_kernel gather_scatter__kernel_systems_refs_featgraph__graph_kernel
  .amdhsa_next_free_vgpr 128
  .amdhsa_next_free_sgpr 64
  .amdhsa_accum_offset 128
  .amdhsa_group_segment_fixed_size 0
  .amdhsa_kernarg_size 64
  .amdhsa_user_sgpr_count 2
  .amdhsa_user_sgpr_kernarg_segment_ptr 1
  .amdhsa_system_sgpr_workgroup_id_x 1
  .amdhsa_float_denorm_mode_32 3
.end_amdhsa_kernel
```
